```python
import torch

def _softmax(x, axis=-1):
    return torch.softmax(x, dim=axis)
def _gelu(x):
    return torch.nn.functional.gelu(x, approximate="tanh")
def _silu(x):
    return torch.nn.functional.silu(x)
def _sigmoid(x):
    return torch.sigmoid(x)
def _layernorm(x, axis=-1, eps=1e-5):
    m = x.mean(dim=axis, keepdim=True)
    v = x.var(dim=axis, keepdim=True, unbiased=False)
    return (x - m) / torch.sqrt(v + eps)
def _scatter_add(tgt, idx, src, axis=0):
    return tgt.clone().index_add_(axis, idx, src)
def _segment_sum(src, seg, n):
    out = torch.zeros((n,) + src.shape[1:], dtype=src.dtype)
    return out.index_add_(0, seg, src)
def _pad(x, pw):
    flat = tuple(v for pair in reversed(pw) for v in pair)
    return torch.nn.functional.pad(x, flat)

kernel_name = 'standalone__gqa_softmax__sampling'

def setup_inputs():

    _w = (lambda a: (lambda t: t.to(torch.bfloat16) if t.is_floating_point() else t)(torch.as_tensor(a)))
    B, Hq, Hkv, Sq, Sk, D = 16, 32, 8, 16, 4096, 128
    return {
        "q": _w((lambda *s: torch.randn(*s, dtype=torch.bfloat16) * 0.8)(B, Hq, Sq, D)),
        "k": _w((lambda *s: torch.randn(*s, dtype=torch.bfloat16) * 0.8)(B, Hkv, Sk, D)),
        "v": _w((lambda *s: torch.randn(*s, dtype=torch.bfloat16) * 0.05)(B, Hkv, Sk, D)),
    }

def reference(q, k, v):
    B, Hq, Sq, D = q.shape
    Hkv = k.shape[1]
    rep = Hq // Hkv
    k = (lambda x, n, axis: torch.repeat_interleave(x, n, dim=axis))(k, rep, axis=1)
    v = (lambda x, n, axis: torch.repeat_interleave(x, n, dim=axis))(v, rep, axis=1)
    scale = D ** -0.5
    scores = torch.einsum("bhqd,bhkd->bhqk", q, k) * scale
    p = _softmax(scores, axis=-1)
    return torch.einsum("bhqk,bhkd->bhqd", p, v)
```

```asm
; @launch grid=(256,1,1) block=(384,1,1) lds=156416
.amdgcn_target "amdgcn-amd-amdhsa--gfx950"
.text
.globl standalone__gqa_softmax__sampling_kernel
.p2align 12
.p2align 8
.type standalone__gqa_softmax__sampling_kernel,@function
standalone__gqa_softmax__sampling_kernel:
    s_load_dwordx8 s[4:11], s[0:1], 0
    s_load_dwordx4 s[28:31], s[0:1], 32
    s_cmp_ge_u32 s2, 256
    s_cbranch_scc1 standalone__gqa_softmax__sampling_kernel_done
    v_lshrrev_b32 v1, 6, v0
    v_and_b32 v0, 63, v0
    v_readfirstlane_b32 s20, v1
    s_bfe_u32 s21, s2, 0x10002
    s_bfe_u32 s3, s2, 0x20004
    s_lshl_b32 s3, s3, 1
    s_or_b32 s21, s21, s3
    s_bfe_u32 s3, s2, 0x20000
    s_lshl_b32 s3, s3, 3
    s_or_b32 s21, s21, s3
    s_bfe_u32 s3, s2, 0x20006
    s_lshl_b32 s3, s3, 5
    s_or_b32 s21, s21, s3
    s_bfe_u32 s22, s2, 0x10003
    v_mov_b32 v13, 155648
    s_cmp_eq_u32 s20, 0
    s_cbranch_scc1 standalone__gqa_softmax__sampling_kernel_loader
    s_cmp_lg_u32 s20, 1
    s_cbranch_scc1 standalone__gqa_softmax__sampling_kernel_nopf
    s_getpc_b64 s[12:13]
standalone__gqa_softmax__sampling_kernel_pc:
    v_lshlrev_b32 v8, 7, v0
    v_min_u32 v8, standalone__gqa_softmax__sampling_kernel_done-standalone__gqa_softmax__sampling_kernel_pc, v8
    v_mov_b32 v9, s13
    v_add_co_u32 v8, vcc, s12, v8
    s_nop 1
    v_addc_co_u32 v9, vcc, 0, v9, vcc
    global_load_dword v14, v[8:9], off
standalone__gqa_softmax__sampling_kernel_nopf:
    v_mov_b32 v6, 0
    v_mov_b32 v7, 0
    v_lshl_add_u32 v1, v0, 3, v13
    ds_write_b64 v1, v[6:7]
    s_waitcnt lgkmcnt(0)
    s_barrier
    s_branch standalone__gqa_softmax__sampling_kernel_notloader
standalone__gqa_softmax__sampling_kernel_loader:
    s_setprio 3
    v_and_b32 v3, 3, v0
    v_bfe_u32 v8, v0, 4, 1
    v_lshlrev_b32 v1, 1, v8
    v_xor_b32 v3, v3, v1
    v_lshrrev_b32 v1, 5, v0
    v_lshl_add_u32 v3, v1, 2, v3
    v_lshlrev_b32 v3, 4, v3
    v_bfe_u32 v1, v0, 2, 3
    v_lshl_add_u32 v24, v1, 8, v3
    v_xor_b32 v25, 48, v24
    v_add_u32 v26, 2048, v24
    v_add_u32 v27, 3072, v25
    v_add_u32 v25, 1024, v25
    v_lshl_add_u32 v4, v8, 15, v3
    v_bfe_u32 v1, v0, 2, 1
    v_lshl_add_u32 v4, v1, 11, v4
    v_bfe_u32 v1, v0, 3, 1
    v_lshl_add_u32 v4, v1, 12, v4
    v_xor_b32 v5, 48, v4
    v_add_u32 v6, 63488, v4
    v_add_u32 v7, 63488, v5
    v_add_u32 v5, 0, v5
    s_lshl_b32 s18, s22, 19
    s_bitcmp1_b32 s2, 3
    s_cselect_b32 s3, 131072, 0
    s_or_b32 s18, s18, s3
    s_bitcmp1_b32 s2, 2
    s_cselect_b32 s3, 262144, 0
    s_or_b32 s18, s18, s3
    s_lshl_b32 s24, s21, 20
    s_mov_b32 s14, 0x100000
    s_mov_b32 s15, 0x20000
    s_lshl_b32 s38, s21, 14
    s_movk_i32 s42, 0x4000
    s_mov_b32 s43, s15
    s_waitcnt lgkmcnt(0)
    s_add_u32 s40, s4, s38
    s_addc_u32 s41, s5, 0
    s_and_b32 s41, s41, 0xffff
    s_add_u32 s12, s6, s24
    s_addc_u32 s13, s7, 0
    s_and_b32 s13, s13, 0xffff
    s_mov_b32 m0, 131072
    s_movk_i32 s3, 0
    buffer_load_dwordx4 v24, s[40:43], s3 offen offset:0 nt lds
    buffer_load_dwordx4 v25, s[40:43], s3 offen offset:1024 nt lds
    buffer_load_dwordx4 v26, s[40:43], s3 offen offset:2048 nt lds
    buffer_load_dwordx4 v27, s[40:43], s3 offen offset:3072 nt lds
    s_mov_b32 m0, 135168
    s_movk_i32 s3, 8192
    buffer_load_dwordx4 v24, s[40:43], s3 offen offset:0 nt lds
    buffer_load_dwordx4 v25, s[40:43], s3 offen offset:1024 nt lds
    buffer_load_dwordx4 v26, s[40:43], s3 offen offset:2048 nt lds
    buffer_load_dwordx4 v27, s[40:43], s3 offen offset:3072 nt lds
    s_mov_b32 m0, 139264
    s_movk_i32 s3, 128
    buffer_load_dwordx4 v24, s[40:43], s3 offen offset:0 nt lds
    buffer_load_dwordx4 v25, s[40:43], s3 offen offset:1024 nt lds
    buffer_load_dwordx4 v26, s[40:43], s3 offen offset:2048 nt lds
    buffer_load_dwordx4 v27, s[40:43], s3 offen offset:3072 nt lds
    s_mov_b32 m0, 143360
    s_movk_i32 s3, 8320
    buffer_load_dwordx4 v24, s[40:43], s3 offen offset:0 nt lds
    buffer_load_dwordx4 v25, s[40:43], s3 offen offset:1024 nt lds
    buffer_load_dwordx4 v26, s[40:43], s3 offen offset:2048 nt lds
    buffer_load_dwordx4 v27, s[40:43], s3 offen offset:3072 nt lds
    s_mov_b32 m0, 65536
    s_xor_b32 s3, s18, 0
    buffer_load_dwordx4 v4, s[12:15], s3 offen offset:0 nt lds
    buffer_load_dwordx4 v5, s[12:15], s3 offen offset:1024 nt lds
    buffer_load_dwordx4 v6, s[12:15], s3 offen offset:2048 nt lds
    buffer_load_dwordx4 v7, s[12:15], s3 offen offset:3072 nt lds
    s_mov_b32 m0, 69632
    s_xor_b32 s3, s18, 512
    buffer_load_dwordx4 v4, s[12:15], s3 offen offset:0 nt lds
    buffer_load_dwordx4 v5, s[12:15], s3 offen offset:1024 nt lds
    buffer_load_dwordx4 v6, s[12:15], s3 offen offset:2048 nt lds
    buffer_load_dwordx4 v7, s[12:15], s3 offen offset:3072 nt lds
    s_mov_b32 m0, 73728
    s_xor_b32 s3, s18, 128
    buffer_load_dwordx4 v4, s[12:15], s3 offen offset:0 nt lds
    buffer_load_dwordx4 v5, s[12:15], s3 offen offset:1024 nt lds
    buffer_load_dwordx4 v6, s[12:15], s3 offen offset:2048 nt lds
    buffer_load_dwordx4 v7, s[12:15], s3 offen offset:3072 nt lds
    s_mov_b32 m0, 77824
    s_xor_b32 s3, s18, 640
    buffer_load_dwordx4 v4, s[12:15], s3 offen offset:0 nt lds
    buffer_load_dwordx4 v5, s[12:15], s3 offen offset:1024 nt lds
    buffer_load_dwordx4 v6, s[12:15], s3 offen offset:2048 nt lds
    buffer_load_dwordx4 v7, s[12:15], s3 offen offset:3072 nt lds
    s_mov_b32 m0, 81920
    s_xor_b32 s3, s18, 8192
    buffer_load_dwordx4 v4, s[12:15], s3 offen offset:0 nt lds
    buffer_load_dwordx4 v5, s[12:15], s3 offen offset:1024 nt lds
    buffer_load_dwordx4 v6, s[12:15], s3 offen offset:2048 nt lds
    buffer_load_dwordx4 v7, s[12:15], s3 offen offset:3072 nt lds
    s_add_u32 s16, s8, s24
    s_addc_u32 s17, s9, 0
    s_and_b32 s17, s17, 0xffff
    s_xor_b32 s25, s18, 8192
    s_mov_b32 s19, 2
    s_mov_b32 s23, 1
    v_and_b32 v22, 1, v0
    v_lshlrev_b32 v22, 7, v22
    v_bfe_u32 v9, v0, 1, 1
    v_lshl_add_u32 v22, v9, 13, v22
    v_bfe_u32 v9, v0, 2, 1
    v_lshl_add_u32 v22, v9, 8, v22
    v_bfe_u32 v9, v0, 3, 1
    v_lshl_add_u32 v22, v9, 18, v22
    v_bfe_u32 v9, v0, 4, 1
    v_lshl_add_u32 v22, v9, 17, v22
    v_bfe_u32 v9, v0, 5, 1
    v_lshl_add_u32 v22, v9, 14, v22
    v_xor_b32 v22, s18, v22
    s_mov_b32 s27, 81920
    s_mov_b32 s32, 0x1ffff
    s_mov_b32 s33, 16
    s_mov_b32 s34, 8
    s_movk_i32 s35, 512
    s_lshl_b32 s36, s22, 7
    v_lshl_add_u32 v10, v0, 2, v13
    v_and_b32 v8, 3, v0
    v_lshl_add_u32 v8, v8, 2, v13
    s_barrier
    s_branch standalone__gqa_softmax__sampling_kernel_g1
standalone__gqa_softmax__sampling_kernel_g0:
    s_mov_b32 m0, s27
    s_cmp_ge_u32 s34, 16
    s_cbranch_scc1 standalone__gqa_softmax__sampling_kernel_hi0
    s_cmp_lt_u32 s34, 8
    s_cbranch_scc1 standalone__gqa_softmax__sampling_kernel_lo0
    s_add_i32 s3, s33, -18
    s_waitcnt vmcnt(18)
standalone__gqa_softmax__sampling_kernel_w0:
    buffer_load_dwordx4 v4, s[12:15], s25 offen offset:0 nt lds
    v_mov_b32 v11, s3
    ds_max_i32 v10, v11 offset:4
    buffer_load_dwordx4 v5, s[12:15], s25 offen offset:1024 nt lds
    buffer_load_dwordx4 v6, s[12:15], s25 offen offset:2048 nt lds
    buffer_load_dwordx4 v7, s[12:15], s25 offen offset:3072 nt lds
standalone__gqa_softmax__sampling_kernel_g1:
    s_add_u32 m0, s27, 0x1000
    s_add_u32 s25, s25, 512
    s_cmp_ge_u32 s34, 12
    s_cbranch_scc1 standalone__gqa_softmax__sampling_kernel_hi1
    s_cmp_lt_u32 s34, 4
    s_cbranch_scc1 standalone__gqa_softmax__sampling_kernel_lo1
    s_add_i32 s3, s33, -14
    s_waitcnt vmcnt(18)
standalone__gqa_softmax__sampling_kernel_w1:
    buffer_load_dwordx4 v4, s[12:15], s25 offen offset:0 nt lds
    v_mov_b32 v11, s3
    ds_max_i32 v10, v11 offset:4
    ds_read_b32 v9, v8 offset:272
    ds_read_b32 v12, v13 offset:288
    buffer_load_dwordx4 v5, s[12:15], s25 offen offset:1024 nt lds
    buffer_load_dwordx4 v6, s[12:15], s25 offen offset:2048 nt lds
    buffer_load_dwordx4 v7, s[12:15], s25 offen offset:3072 nt lds
    s_add_u32 s19, s19, s23
    s_addk_i32 s27, 0x2000
    s_and_b32 s27, s27, s32
    s_cselect_b32 s32, s32, 0xffff
    s_add_u32 s33, s33, 8
    s_sub_u32 s39, s33, 56
    s_cmpk_ge_u32 s33, 128
    s_cselect_b32 s39, s39, 0
    s_brev_b32 s37, s33
    s_bfe_u32 s37, s37, 0x2001b
    s_add_u32 s37, s37, 8
    s_cmp_eq_u32 s33, s35
    s_cbranch_scc1 standalone__gqa_softmax__sampling_kernel_change
standalone__gqa_softmax__sampling_kernel_chk:
    v_readlane_b32 s25, v22, s19
    s_waitcnt lgkmcnt(0)
    v_readfirstlane_b32 s34, v12
    v_cmp_gt_u32 vcc, s39, v9
    s_add_i32 s34, s34, s37
    s_cbranch_vccz standalone__gqa_softmax__sampling_kernel_g0
    ds_read_b32 v9, v8 offset:272
    s_branch standalone__gqa_softmax__sampling_kernel_chk
standalone__gqa_softmax__sampling_kernel_hi0:
    s_add_i32 s3, s33, -28
    s_cmp_ge_u32 s34, 32
    s_waitcnt vmcnt(28)
    s_cbranch_scc1 standalone__gqa_softmax__sampling_kernel_w0
    s_add_i32 s3, s33, -22
    s_cmp_ge_u32 s34, 24
    s_waitcnt vmcnt(22)
    s_cbranch_scc1 standalone__gqa_softmax__sampling_kernel_w0
    s_add_i32 s3, s33, -20
    s_waitcnt vmcnt(20)
    s_branch standalone__gqa_softmax__sampling_kernel_w0
standalone__gqa_softmax__sampling_kernel_lo0:
    s_add_i32 s3, s33, -16
    s_waitcnt vmcnt(16)
    s_branch standalone__gqa_softmax__sampling_kernel_w0
standalone__gqa_softmax__sampling_kernel_hi1:
    s_add_i32 s3, s33, -24
    s_cmp_ge_u32 s34, 28
    s_waitcnt vmcnt(28)
    s_cbranch_scc1 standalone__gqa_softmax__sampling_kernel_w1
    s_add_i32 s3, s33, -18
    s_cmp_ge_u32 s34, 20
    s_waitcnt vmcnt(22)
    s_cbranch_scc1 standalone__gqa_softmax__sampling_kernel_w1
    s_add_i32 s3, s33, -16
    s_waitcnt vmcnt(20)
    s_branch standalone__gqa_softmax__sampling_kernel_w1
standalone__gqa_softmax__sampling_kernel_lo1:
    s_add_i32 s3, s33, -12
    s_waitcnt vmcnt(16)
    s_branch standalone__gqa_softmax__sampling_kernel_w1
standalone__gqa_softmax__sampling_kernel_change:
    s_cmpk_lg_u32 s33, 1024
    s_cbranch_scc1 standalone__gqa_softmax__sampling_kernel_more
    v_mov_b32 v11, 1000
    s_waitcnt vmcnt(24)
    ds_max_i32 v10, v11 offset:4
    v_mov_b32 v11, 1008
    s_waitcnt vmcnt(16)
    ds_max_i32 v10, v11 offset:4
    v_mov_b32 v11, 1016
    s_waitcnt vmcnt(8)
    ds_max_i32 v10, v11 offset:4
    v_mov_b32 v11, 1024
    s_waitcnt vmcnt(0)
    ds_max_i32 v10, v11 offset:4
    s_endpgm
standalone__gqa_softmax__sampling_kernel_more:
    s_cmpk_lg_u32 s33, 512
    s_cbranch_scc1 standalone__gqa_softmax__sampling_kernel_halves
    v_xor_b32 v22, s36, v22
    s_mov_b64 s[12:13], s[16:17]
    s_mov_b32 s19, 0
    s_movk_i32 s35, 880
    s_branch standalone__gqa_softmax__sampling_kernel_chk
standalone__gqa_softmax__sampling_kernel_halves:
    s_mov_b32 s23, 2
    s_cmpk_eq_u32 s33, 880
    s_cselect_b32 s19, 47, 46
    s_movk_i32 s35, 1024
    s_cmovk_i32 s35, 952
    s_branch standalone__gqa_softmax__sampling_kernel_chk
standalone__gqa_softmax__sampling_kernel_notloader:
    s_sub_u32 s20, s20, 2
    s_mov_b32 s47, 0x20000
    s_cmp_ge_i32 s20, 0
    s_cbranch_scc1 standalone__gqa_softmax__sampling_kernel_compute
    s_add_u32 s84, s30, 131072
    s_addc_u32 s85, s31, 0
    s_and_b32 s85, s85, 0xffff
    s_mov_b32 s86, 0x8400
    s_mov_b32 s87, 0x20000
    s_mov_b32 s52, s28
    s_and_b32 s53, s29, 0xffff
    s_mov_b32 s54, 0x100
    s_mov_b32 s55, 0x20000
    s_mov_b32 s48, s30
    s_and_b32 s49, s31, 0xffff
    s_mov_b32 s50, 131072
    s_mov_b32 s51, 0x20000
    s_lshl_b32 s25, s21, 14
    s_add_u32 s44, s10, s25
    s_addc_u32 s45, s11, 0
    s_and_b32 s45, s45, 0xffff
    s_movk_i32 s46, 0x4000
    s_xor_b32 s3, s2, 8
    s_lshl_b32 s59, s3, 7
    s_lshl_b32 s58, s2, 7
    s_lshl_b32 s56, s2, 9
    s_lshr_b32 s60, s3, 3
    s_getreg_b32 s61, hwreg(HW_REG_XCC_ID, 0, 4)
    s_add_u32 s61, s61, 1
    s_lshl_b32 s61, s61, 27
    s_mov_b32 s43, 0
    v_lshrrev_b32 v11, 3, v0
    v_and_b32 v12, 7, v0
    v_lshlrev_b32 v12, 4, v12
    v_lshl_add_u32 v12, v11, 8, v12
    s_lshl_b32 s3, s22, 7
    s_xor_b32 s3, s3, 0x80
    v_add_u32 v15, s3, v12
    v_mov_b32 v2, 1
    v_lshlrev_b32 v3, 2, v0
    v_lshlrev_b32 v1, 4, v0
    v_add_u32 v10, 155920, v3
    v_add_u32 v11, 65536, v1
    s_cmp_lg_u32 s2, 0
    s_cbranch_scc1 standalone__gqa_softmax__sampling_kernel_reset_done
    v_mov_b32 v8, 0
    v_mov_b32 v9, 0
    s_mov_b32 s3, 0
standalone__gqa_softmax__sampling_kernel_reset:
    buffer_store_dwordx4 v[6:9], v1, s[84:87], s3 offen sc1
    s_addk_i32 s3, 0x400
    s_cmp_lt_u32 s3, s86
    s_cbranch_scc1 standalone__gqa_softmax__sampling_kernel_reset
    s_mov_b32 exec_hi, 0
    s_waitcnt vmcnt(0)
    buffer_store_dword v2, v3, s[52:55], 0 offen sc1
standalone__gqa_softmax__sampling_kernel_reset_done:
    s_mov_b64 exec, 1
    s_lshl_b32 s3, s21, 20
    s_lshl_b32 s12, s22, 19
    s_or_b32 s3, s3, s12
    s_load_dword s12, s[8:9], s3 glc
standalone__gqa_softmax__sampling_kernel_early:
    ds_read_b32 v4, v13 offset:4
    s_waitcnt lgkmcnt(0)
    v_readfirstlane_b32 s3, v4
    s_cmp_lt_i32 s3, 112
    s_cbranch_scc1 standalone__gqa_softmax__sampling_kernel_early
standalone__gqa_softmax__sampling_kernel_poll0:
    buffer_load_dword v4, v6, s[52:55], 0 offen sc1
    s_waitcnt vmcnt(0)
    v_readfirstlane_b32 s3, v4
    s_cmp_eq_u32 s3, 0
    s_cbranch_scc1 standalone__gqa_softmax__sampling_kernel_poll0
    s_and_b32 s39, s2, 7
    s_lshl_b32 s39, s39, 7
    s_add_u32 s39, s39, 0x8000
    s_lshr_b32 s62, s2, 3
    s_lshl2_add_u32 s62, s62, s39
    buffer_load_dword v4, v6, s[84:87], s39 offen sc1
    s_waitcnt vmcnt(0)
    s_movk_i32 s38, 288
    s_bitcmp1_b32 s61, 27
    s_cmovk_i32 s38, 384
    s_mov_b32 s33, 0
standalone__gqa_softmax__sampling_kernel_rep:
    ds_read_b32 v4, v13 offset:4
    s_waitcnt lgkmcnt(0)
    v_readfirstlane_b32 s3, v4
    s_cmp_lt_i32 s3, s33
    s_cbranch_scc1 standalone__gqa_softmax__sampling_kernel_rep
    s_cmpk_ge_i32 s3, 936
    s_cbranch_scc1 standalone__gqa_softmax__sampling_kernel_balanced
    v_or_b32 v4, s61, v4
    buffer_store_dword v4, v6, s[84:87], s62 offen
    s_mov_b32 exec_lo, -1
    buffer_load_dword v5, v3, s[84:87], s39 offen nt
    s_add_u32 s33, s3, 16
    s_min_u32 s33, s33, 936
    s_lshl_b32 s63, s3, 5
    s_sub_u32 s63, s63, s38
    s_waitcnt vmcnt(0)
    v_readlane_b32 s43, v5, s60
    v_and_b32 v5, 0x7ffffff, v5
    v_cmp_eq_u32 vcc, 0, v5
    s_nop 0
    v_add_u32_dpp v5, v5, v5 row_shr:1 row_mask:0xf bank_mask:0xf bound_ctrl:0
    s_nop 1
    v_add_u32_dpp v5, v5, v5 row_shr:2 row_mask:0xf bank_mask:0xf bound_ctrl:0
    s_nop 1
    v_add_u32_dpp v5, v5, v5 row_shr:4 row_mask:0xf bank_mask:0xf bound_ctrl:0
    s_nop 1
    v_add_u32_dpp v5, v5, v5 row_shr:8 row_mask:0xf bank_mask:0xf bound_ctrl:0
    s_nop 1
    v_readlane_b32 s3, v5, 15
    v_readlane_b32 s40, v5, 31
    s_mov_b32 exec_lo, 1
    s_add_u32 s3, s3, s40
    s_sub_i32 s3, s3, s63
    s_ashr_i32 s3, s3, 5
    s_cmp_eq_u32 vcc_lo, 0
    s_cselect_b32 s3, s3, 0
    s_max_i32 s3, s3, -8
    s_min_i32 s3, s3, 20
    v_mov_b32 v4, s3
    ds_write_b32 v13, v4 offset:288
    s_branch standalone__gqa_softmax__sampling_kernel_rep
standalone__gqa_softmax__sampling_kernel_balanced:
    s_and_b32 s43, s43, 0xf8000000
    s_mov_b32 exec_lo, 15
standalone__gqa_softmax__sampling_kernel_stored:
    ds_read_b32 v4, v10
    s_waitcnt lgkmcnt(0)
    v_cmp_gt_u32 vcc, 952, v4
    s_cbranch_vccnz standalone__gqa_softmax__sampling_kernel_stored
    s_mov_b64 exec, -1
    ds_read_b128 v[16:19], v11 offset:0
    ds_read_b128 v[20:23], v11 offset:1024
    ds_read_b128 v[24:27], v11 offset:2048
    ds_read_b128 v[28:31], v11 offset:3072
    ds_read_b128 v[32:35], v11 offset:4096
    ds_read_b128 v[36:39], v11 offset:5120
    ds_read_b128 v[40:43], v11 offset:6144
    ds_read_b128 v[44:47], v11 offset:7168
    ds_read_b128 v[48:51], v11 offset:8192
    s_cmp_lg_u32 s43, s61
    s_cbranch_scc1 standalone__gqa_softmax__sampling_kernel_through
    s_movk_i32 s3, 0
    s_waitcnt lgkmcnt(8)
    buffer_store_dwordx4 v[16:19], v15, s[44:47], s3 offen offset:0
    s_waitcnt lgkmcnt(7)
    buffer_store_dwordx4 v[20:23], v15, s[44:47], s3 offen offset:2048
    s_movk_i32 s3, 4096
    s_waitcnt lgkmcnt(6)
    buffer_store_dwordx4 v[24:27], v15, s[44:47], s3 offen offset:0
    s_waitcnt lgkmcnt(5)
    buffer_store_dwordx4 v[28:31], v15, s[44:47], s3 offen offset:2048
    s_movk_i32 s3, 8192
    s_waitcnt lgkmcnt(4)
    buffer_store_dwordx4 v[32:35], v15, s[44:47], s3 offen offset:0
    s_waitcnt lgkmcnt(3)
    buffer_store_dwordx4 v[36:39], v15, s[44:47], s3 offen offset:2048
    s_movk_i32 s3, 12288
    s_waitcnt lgkmcnt(2)
    buffer_store_dwordx4 v[40:43], v15, s[44:47], s3 offen offset:0
    s_waitcnt lgkmcnt(1)
    buffer_store_dwordx4 v[44:47], v15, s[44:47], s3 offen offset:2048
    s_mov_b32 exec_hi, 0
    s_waitcnt lgkmcnt(0)
    buffer_store_dwordx4 v[48:51], v1, s[48:51], s56 offen
standalone__gqa_softmax__sampling_kernel_sent:
    s_waitcnt vmcnt(0)
    buffer_store_dword v2, v3, s[84:87], s58 offen sc1
    s_mov_b32 exec_lo, 1
standalone__gqa_softmax__sampling_kernel_poll1:
    s_mov_b32 s39, 50
standalone__gqa_softmax__sampling_kernel_poll2:
    s_buffer_load_dword s3, s[84:87], s59 glc
    s_waitcnt lgkmcnt(0)
    s_cmp_lg_u32 s3, 0
    s_cbranch_scc1 standalone__gqa_softmax__sampling_kernel_ready
    s_sub_u32 s39, s39, 1
    s_cmp_lg_u32 s39, 0
    s_cbranch_scc1 standalone__gqa_softmax__sampling_kernel_poll2
    buffer_load_dword v4, v6, s[84:87], s59 offen sc1
    s_waitcnt vmcnt(0)
    v_readfirstlane_b32 s3, v4
    s_cmp_eq_u32 s3, 0
    s_cbranch_scc1 standalone__gqa_softmax__sampling_kernel_poll1
standalone__gqa_softmax__sampling_kernel_ready:
    ds_write_b32 v13, v2
    s_endpgm
standalone__gqa_softmax__sampling_kernel_through:
    s_movk_i32 s3, 0
    s_waitcnt lgkmcnt(8)
    buffer_store_dwordx4 v[16:19], v15, s[44:47], s3 offen offset:0 sc1
    s_waitcnt lgkmcnt(7)
    buffer_store_dwordx4 v[20:23], v15, s[44:47], s3 offen offset:2048 sc1
    s_movk_i32 s3, 4096
    s_waitcnt lgkmcnt(6)
    buffer_store_dwordx4 v[24:27], v15, s[44:47], s3 offen offset:0 sc1
    s_waitcnt lgkmcnt(5)
    buffer_store_dwordx4 v[28:31], v15, s[44:47], s3 offen offset:2048 sc1
    s_movk_i32 s3, 8192
    s_waitcnt lgkmcnt(4)
    buffer_store_dwordx4 v[32:35], v15, s[44:47], s3 offen offset:0 sc1
    s_waitcnt lgkmcnt(3)
    buffer_store_dwordx4 v[36:39], v15, s[44:47], s3 offen offset:2048 sc1
    s_movk_i32 s3, 12288
    s_waitcnt lgkmcnt(2)
    buffer_store_dwordx4 v[40:43], v15, s[44:47], s3 offen offset:0 sc1
    s_waitcnt lgkmcnt(1)
    buffer_store_dwordx4 v[44:47], v15, s[44:47], s3 offen offset:2048 sc1
    s_mov_b32 exec_hi, 0
    s_waitcnt lgkmcnt(0)
    buffer_store_dwordx4 v[48:51], v1, s[48:51], s56 offen sc1
    s_branch standalone__gqa_softmax__sampling_kernel_sent
standalone__gqa_softmax__sampling_kernel_compute:
    s_mov_b32 s40, 0x3e0293ee
    s_mov_b32 s35, 81920
    s_mov_b32 s34, 0x1ffff
    s_mov_b32 s41, 0
    s_mov_b32 s42, 16
    s_movk_i32 s33, 0x78
    v_lshrrev_b32 v16, 4, v0
    v_bfe_u32 v17, v0, 2, 2
    v_lshlrev_b32 v19, 1, v17
    v_lshrrev_b32 v19, v19, s33
    v_xor_b32 v19, v19, v16
    v_and_b32 v19, 3, v19
    v_lshlrev_b32 v19, 4, v19
    v_and_b32 v18, 7, v0
    v_lshl_add_u32 v19, v18, 6, v19
    v_bfe_u32 v18, v0, 3, 1
    v_lshl_add_u32 v4, v18, 10, v19
    v_add_u32 v5, 65536, v4
    v_mov_b32 v2, s40
    v_mov_b32 v9, 0xff800000
    v_mov_b32 v48, 0
    v_mov_b32 v49, 0
    s_lshl_b32 s3, s20, 11
    s_add_u32 s36, s3, 147456
    v_and_b32 v16, 15, v0
    v_lshl_add_u32 v7, v16, 2, s36
    s_add_u32 s36, s3, 65536
    v_lshl_add_u32 v15, v0, 4, s36
    s_lshl2_add_u32 s3, s20, 155920
    v_lshl_add_u32 v3, v0, 2, v13
    v_add_u32 v3, 512, v3
    v_writelane_b32 v3, s3, 0
    s_lshl_b32 s3, s20, 11
    s_add_u32 s3, s3, 131072
    v_add_u32 v12, s3, v4
standalone__gqa_softmax__sampling_kernel_waitq:
    ds_read_b64 v[10:11], v13
    s_waitcnt lgkmcnt(0)
    v_readfirstlane_b32 s43, v11
    s_cmp_lt_i32 s43, 1
    s_cbranch_scc1 standalone__gqa_softmax__sampling_kernel_waitq
    ds_read_b128 v[16:19], v12 offset:0
    ds_read_b128 v[20:23], v12 offset:512
    ds_read_b128 v[24:27], v12 offset:8192
    ds_read_b128 v[28:31], v12 offset:8704
standalone__gqa_softmax__sampling_kernel_WK:
    s_waitcnt lgkmcnt(0)
    v_readfirstlane_b32 s43, v11
    s_cmp_lt_i32 s43, s42
    s_cbranch_scc1 standalone__gqa_softmax__sampling_kernel_spinK
    ds_read_b128 v[52:55], v5 offset:0
    ds_read_b128 v[56:59], v5 offset:512
    ds_read_b128 v[60:63], v5 offset:8192
    ds_read_b128 v[64:67], v5 offset:8704
    ds_read_b128 v[68:71], v5 offset:2048
    ds_read_b128 v[72:75], v5 offset:2560
    ds_read_b128 v[76:79], v5 offset:10240
    s_waitcnt lgkmcnt(5)
    v_mfma_f32_16x16x32_bf16 v[32:35], v[52:55], v[16:19], 0
    v_mfma_f32_16x16x32_bf16 v[32:35], v[56:59], v[20:23], v[32:35]
    ds_read_b128 v[52:55], v5 offset:10752
    s_waitcnt lgkmcnt(4)
    v_mfma_f32_16x16x32_bf16 v[32:35], v[60:63], v[24:27], v[32:35]
    ds_read_b128 v[56:59], v5 offset:4096
    v_mfma_f32_16x16x32_bf16 v[32:35], v[64:67], v[28:31], v[32:35]
    ds_read_b128 v[60:63], v5 offset:4608
    s_waitcnt lgkmcnt(4)
    v_mfma_f32_16x16x32_bf16 v[36:39], v[68:71], v[16:19], 0
    ds_read_b128 v[64:67], v5 offset:12288
    v_mfma_f32_16x16x32_bf16 v[36:39], v[72:75], v[20:23], v[36:39]
    ds_read_b128 v[68:71], v5 offset:12800
    s_waitcnt lgkmcnt(4)
    v_mfma_f32_16x16x32_bf16 v[36:39], v[76:79], v[24:27], v[36:39]
    ds_read_b128 v[72:75], v5 offset:6144
    v_mfma_f32_16x16x32_bf16 v[36:39], v[52:55], v[28:31], v[36:39]
    ds_read_b128 v[76:79], v5 offset:6656
    s_waitcnt lgkmcnt(4)
    v_mfma_f32_16x16x32_bf16 v[40:43], v[56:59], v[16:19], 0
    ds_read_b128 v[52:55], v5 offset:14336
    v_mfma_f32_16x16x32_bf16 v[40:43], v[60:63], v[20:23], v[40:43]
    ds_read_b128 v[56:59], v5 offset:14848
    s_waitcnt lgkmcnt(4)
    v_mfma_f32_16x16x32_bf16 v[40:43], v[64:67], v[24:27], v[40:43]
    v_add_u32 v5, s35, v4
    s_addk_i32 s35, 0x4000
    v_mfma_f32_16x16x32_bf16 v[40:43], v[68:71], v[28:31], v[40:43]
    v_max3_f32 v12, v32, v33, v34
    s_waitcnt lgkmcnt(2)
    v_mfma_f32_16x16x32_bf16 v[44:47], v[72:75], v[16:19], 0
    s_and_b32 s35, s35, s34
    s_cselect_b32 s34, s34, 0xffff
    v_mfma_f32_16x16x32_bf16 v[44:47], v[76:79], v[20:23], v[44:47]
    s_sub_u32 s37, s42, 144
    s_waitcnt lgkmcnt(0)
    v_mfma_f32_16x16x32_bf16 v[44:47], v[52:55], v[24:27], v[44:47]
    v_max3_f32 v12, v35, v36, v12
    v_mfma_f32_16x16x32_bf16 v[44:47], v[56:59], v[28:31], v[44:47]
    v_max3_f32 v12, v37, v38, v12
    v_mov_b32 v1, s42
    ds_write_b32 v3, v1
    s_add_u32 s42, s42, 16
    v_max3_f32 v12, v39, v40, v12
    v_max3_f32 v12, v41, v42, v12
    s_nop 1
    v_max3_f32 v12, v43, v44, v12
    v_max3_f32 v12, v45, v46, v12
    v_max_f32 v14, v47, v12
    v_max_f32 v12, v47, v12
    s_nop 1
    v_permlane32_swap_b32 v12, v14
    v_max_f32 v8, v12, v14
    v_max_f32 v12, v12, v14
    s_nop 1
    v_permlane16_swap_b32 v12, v8
    v_max_f32 v12, v12, v8
    v_mul_f32 v12, s40, v12
    v_mov_b32 v6, v9
    v_max_f32 v9, v12, v9
    v_sub_f32 v14, v6, v9
    v_exp_f32 v14, v14
    v_pk_fma_f32 v[32:33], v[32:33], v[2:3], v[8:9] op_sel:[0,0,1] op_sel_hi:[1,0,1] neg_lo:[0,0,1] neg_hi:[0,0,1]
    v_pk_fma_f32 v[34:35], v[34:35], v[2:3], v[8:9] op_sel:[0,0,1] op_sel_hi:[1,0,1] neg_lo:[0,0,1] neg_hi:[0,0,1]
    ds_write_b32 v7, v14
    v_add_u32 v7, 64, v7
    v_pk_fma_f32 v[36:37], v[36:37], v[2:3], v[8:9] op_sel:[0,0,1] op_sel_hi:[1,0,1] neg_lo:[0,0,1] neg_hi:[0,0,1]
    v_pk_fma_f32 v[38:39], v[38:39], v[2:3], v[8:9] op_sel:[0,0,1] op_sel_hi:[1,0,1] neg_lo:[0,0,1] neg_hi:[0,0,1]
    v_pk_fma_f32 v[40:41], v[40:41], v[2:3], v[8:9] op_sel:[0,0,1] op_sel_hi:[1,0,1] neg_lo:[0,0,1] neg_hi:[0,0,1]
    v_pk_fma_f32 v[42:43], v[42:43], v[2:3], v[8:9] op_sel:[0,0,1] op_sel_hi:[1,0,1] neg_lo:[0,0,1] neg_hi:[0,0,1]
    v_pk_fma_f32 v[44:45], v[44:45], v[2:3], v[8:9] op_sel:[0,0,1] op_sel_hi:[1,0,1] neg_lo:[0,0,1] neg_hi:[0,0,1]
    v_pk_fma_f32 v[46:47], v[46:47], v[2:3], v[8:9] op_sel:[0,0,1] op_sel_hi:[1,0,1] neg_lo:[0,0,1] neg_hi:[0,0,1]
    v_exp_f32 v32, v32
    v_exp_f32 v33, v33
    v_exp_f32 v34, v34
    v_pk_fma_f32 v[48:49], v[48:49], v[14:15], v[32:33] op_sel_hi:[1,0,1]
    v_exp_f32 v35, v35
    v_exp_f32 v36, v36
    v_exp_f32 v37, v37
    v_exp_f32 v38, v38
    v_pk_add_f32 v[50:51], v[34:35], v[36:37]
    v_exp_f32 v39, v39
    v_exp_f32 v40, v40
    v_pk_add_f32 v[48:49], v[48:49], v[38:39]
    v_exp_f32 v41, v41
    ds_read_b64 v[10:11], v13
    v_exp_f32 v42, v42
    v_pk_add_f32 v[50:51], v[50:51], v[40:41]
    v_exp_f32 v43, v43
    v_exp_f32 v44, v44
    v_pk_add_f32 v[48:49], v[48:49], v[42:43]
    v_exp_f32 v45, v45
    v_exp_f32 v46, v46
    v_pk_add_f32 v[50:51], v[50:51], v[44:45]
    v_exp_f32 v47, v47
    v_pk_add_f32 v[48:49], v[48:49], v[50:51]
    s_cmpk_lt_u32 s37, 160
    v_pk_add_f32 v[48:49], v[48:49], v[46:47]
    s_cbranch_scc1 standalone__gqa_softmax__sampling_kernel_tolds
    s_set_gpr_idx_on s41, gpr_idx(DST)
    v_cvt_pk_bf16_f32 v80, v32, v33
    v_cvt_pk_bf16_f32 v81, v34, v35
    v_cvt_pk_bf16_f32 v82, v36, v37
    v_cvt_pk_bf16_f32 v83, v38, v39
    v_cvt_pk_bf16_f32 v84, v40, v41
    v_cvt_pk_bf16_f32 v85, v42, v43
    v_cvt_pk_bf16_f32 v86, v44, v45
    v_cvt_pk_bf16_f32 v87, v46, v47
    s_set_gpr_idx_off
    s_add_u32 s41, s41, 8
    s_cmpk_le_u32 s42, 512
    s_cbranch_scc1 standalone__gqa_softmax__sampling_kernel_WK
    v_add_f32 v48, v48, v49
    v_mov_b32 v12, v48
    v_lshrrev_b32 v16, 4, v0
    v_bfe_u32 v17, v0, 2, 3
    v_permlane32_swap_b32 v48, v12
    v_add_f32 v48, v48, v12
    v_mov_b32 v12, v48
    v_and_b32 v18, 3, v0
    v_lshlrev_b32 v19, 1, v16
    v_permlane16_swap_b32 v48, v12
    v_add_f32 v48, v48, v12
    v_lshrrev_b32 v19, v19, s33
    v_and_b32 v19, 3, v19
    v_lshlrev_b32 v19, 1, v19
    v_xor_b32 v19, v19, v18
    v_lshlrev_b32 v19, 3, v19
    v_lshl_add_u32 v19, v17, 6, v19
    v_lshrrev_b32 v16, 5, v0
    v_lshl_add_u32 v4, v16, 10, v19
    v_xor_b32 v5, 32, v4
    v_subrev_u32 v7, 2048, v7
    v_subrev_u32 v15, 81920, v15
    v_mov_b32 v16, 0
    v_mov_b32 v17, 0
    v_mov_b32 v18, 0
    v_mov_b32 v19, 0
    v_mov_b32 v20, 0
    v_mov_b32 v21, 0
    v_mov_b32 v22, 0
    v_mov_b32 v23, 0
    v_mov_b32 v24, 0
    v_mov_b32 v25, 0
    v_mov_b32 v26, 0
    v_mov_b32 v27, 0
    v_mov_b32 v28, 0
    v_mov_b32 v29, 0
    v_mov_b32 v30, 0
    v_mov_b32 v31, 0
    v_mov_b32 v32, 0
    v_mov_b32 v33, 0
    v_mov_b32 v34, 0
    v_mov_b32 v35, 0
    v_mov_b32 v36, 0
    v_mov_b32 v37, 0
    v_mov_b32 v38, 0
    v_mov_b32 v39, 0
    v_mov_b32 v40, 0
    v_mov_b32 v41, 0
    v_mov_b32 v42, 0
    v_mov_b32 v43, 0
    v_mov_b32 v44, 0
    v_mov_b32 v45, 0
    v_mov_b32 v46, 0
    v_mov_b32 v47, 0
    s_mov_b32 s35, 0
    s_mov_b32 s41, 0
    s_movk_i32 s42, 512
standalone__gqa_softmax__sampling_kernel_vtop:
    s_sub_u32 s37, s42, 640
    ds_read_b32 v2, v7
    v_add_u32 v7, 64, v7
    v_add_u32 v50, s35, v4
    v_add_u32 v51, s35, v5
    s_addk_i32 s35, 16384
    s_bitset0_b32 s35, 16
    s_add_u32 s42, s42, 8
    s_cmpk_lt_u32 s37, 160
    s_cbranch_scc1 standalone__gqa_softmax__sampling_kernel_fromlds
    s_set_gpr_idx_on s41, gpr_idx(SRC0)
    v_mov_b32 v52, v80
    v_mov_b32 v53, v81
    v_mov_b32 v54, v82
    v_mov_b32 v55, v83
    v_mov_b32 v56, v84
    v_mov_b32 v57, v85
    v_mov_b32 v58, v86
    v_mov_b32 v59, v87
    s_set_gpr_idx_off
    s_add_u32 s41, s41, 8
standalone__gqa_softmax__sampling_kernel_havep:
standalone__gqa_softmax__sampling_kernel_WV0:
    s_waitcnt lgkmcnt(0)
    v_readfirstlane_b32 s43, v11
    s_cmp_lt_i32 s43, s42
    s_cbranch_scc1 standalone__gqa_softmax__sampling_kernel_spinV0
    ds_read_b64_tr_b16 v[60:61], v50 offset:0
    ds_read_b64_tr_b16 v[62:63], v50 offset:2048
    ds_read_b64_tr_b16 v[64:65], v51 offset:0
    ds_read_b64_tr_b16 v[66:67], v51 offset:2048
    ds_read_b64_tr_b16 v[68:69], v50 offset:512
    ds_read_b64_tr_b16 v[70:71], v50 offset:2560
    ds_read_b64_tr_b16 v[72:73], v51 offset:512
    ds_read_b64_tr_b16 v[74:75], v51 offset:2560
    ds_read_b64_tr_b16 v[76:77], v50 offset:4096
    ds_read_b64_tr_b16 v[78:79], v50 offset:6144
    v_pk_mul_f32 v[16:17], v[16:17], v[2:3] op_sel_hi:[1,0]
    v_pk_mul_f32 v[18:19], v[18:19], v[2:3] op_sel_hi:[1,0]
    v_pk_mul_f32 v[20:21], v[20:21], v[2:3] op_sel_hi:[1,0]
    v_pk_mul_f32 v[22:23], v[22:23], v[2:3] op_sel_hi:[1,0]
    v_pk_mul_f32 v[24:25], v[24:25], v[2:3] op_sel_hi:[1,0]
    v_pk_mul_f32 v[26:27], v[26:27], v[2:3] op_sel_hi:[1,0]
    v_pk_mul_f32 v[28:29], v[28:29], v[2:3] op_sel_hi:[1,0]
    v_pk_mul_f32 v[30:31], v[30:31], v[2:3] op_sel_hi:[1,0]
    s_waitcnt lgkmcnt(8)
    v_mfma_f32_16x16x32_bf16 v[16:19], v[60:63], v[52:55], v[16:19]
    s_waitcnt lgkmcnt(6)
    v_mfma_f32_16x16x32_bf16 v[20:23], v[64:67], v[52:55], v[20:23]
    ds_read_b64_tr_b16 v[60:61], v51 offset:4096
    ds_read_b64_tr_b16 v[62:63], v51 offset:6144
    s_waitcnt lgkmcnt(6)
    v_mfma_f32_16x16x32_bf16 v[24:27], v[68:71], v[52:55], v[24:27]
    ds_read_b64_tr_b16 v[64:65], v50 offset:4608
    ds_read_b64_tr_b16 v[66:67], v50 offset:6656
    s_waitcnt lgkmcnt(6)
    v_mfma_f32_16x16x32_bf16 v[28:31], v[72:75], v[52:55], v[28:31]
    ds_read_b64_tr_b16 v[68:69], v51 offset:4608
    ds_read_b64_tr_b16 v[70:71], v51 offset:6656
    ds_read_b64 v[10:11], v13
    s_waitcnt lgkmcnt(7)
    v_mfma_f32_16x16x32_bf16 v[16:19], v[76:79], v[56:59], v[16:19]
    s_waitcnt lgkmcnt(5)
    v_mfma_f32_16x16x32_bf16 v[20:23], v[60:63], v[56:59], v[20:23]
    s_waitcnt lgkmcnt(3)
    v_mfma_f32_16x16x32_bf16 v[24:27], v[64:67], v[56:59], v[24:27]
    s_waitcnt lgkmcnt(1)
    v_mfma_f32_16x16x32_bf16 v[28:31], v[68:71], v[56:59], v[28:31]
    v_mov_b32 v1, s42
    ds_write_b32 v3, v1
    s_add_u32 s42, s42, 8
standalone__gqa_softmax__sampling_kernel_WV1:
    s_waitcnt lgkmcnt(0)
    v_readfirstlane_b32 s43, v11
    s_cmp_lt_i32 s43, s42
    s_cbranch_scc1 standalone__gqa_softmax__sampling_kernel_spinV1
    ds_read_b64_tr_b16 v[60:61], v50 offset:8192
    ds_read_b64_tr_b16 v[62:63], v50 offset:10240
    ds_read_b64_tr_b16 v[64:65], v51 offset:8192
    ds_read_b64_tr_b16 v[66:67], v51 offset:10240
    ds_read_b64_tr_b16 v[68:69], v50 offset:8704
    ds_read_b64_tr_b16 v[70:71], v50 offset:10752
    ds_read_b64_tr_b16 v[72:73], v51 offset:8704
    ds_read_b64_tr_b16 v[74:75], v51 offset:10752
    ds_read_b64_tr_b16 v[76:77], v50 offset:12288
    ds_read_b64_tr_b16 v[78:79], v50 offset:14336
    v_pk_mul_f32 v[32:33], v[32:33], v[2:3] op_sel_hi:[1,0]
    v_pk_mul_f32 v[34:35], v[34:35], v[2:3] op_sel_hi:[1,0]
    v_pk_mul_f32 v[36:37], v[36:37], v[2:3] op_sel_hi:[1,0]
    v_pk_mul_f32 v[38:39], v[38:39], v[2:3] op_sel_hi:[1,0]
    v_pk_mul_f32 v[40:41], v[40:41], v[2:3] op_sel_hi:[1,0]
    v_pk_mul_f32 v[42:43], v[42:43], v[2:3] op_sel_hi:[1,0]
    v_pk_mul_f32 v[44:45], v[44:45], v[2:3] op_sel_hi:[1,0]
    v_pk_mul_f32 v[46:47], v[46:47], v[2:3] op_sel_hi:[1,0]
    s_waitcnt lgkmcnt(8)
    v_mfma_f32_16x16x32_bf16 v[32:35], v[60:63], v[52:55], v[32:35]
    s_waitcnt lgkmcnt(6)
    v_mfma_f32_16x16x32_bf16 v[36:39], v[64:67], v[52:55], v[36:39]
    ds_read_b64_tr_b16 v[60:61], v51 offset:12288
    ds_read_b64_tr_b16 v[62:63], v51 offset:14336
    s_waitcnt lgkmcnt(6)
    v_mfma_f32_16x16x32_bf16 v[40:43], v[68:71], v[52:55], v[40:43]
    ds_read_b64_tr_b16 v[64:65], v50 offset:12800
    ds_read_b64_tr_b16 v[66:67], v50 offset:14848
    s_waitcnt lgkmcnt(6)
    v_mfma_f32_16x16x32_bf16 v[44:47], v[72:75], v[52:55], v[44:47]
    ds_read_b64_tr_b16 v[68:69], v51 offset:12800
    ds_read_b64_tr_b16 v[70:71], v51 offset:14848
    ds_read_b64 v[10:11], v13
    s_waitcnt lgkmcnt(7)
    v_mfma_f32_16x16x32_bf16 v[32:35], v[76:79], v[56:59], v[32:35]
    s_waitcnt lgkmcnt(5)
    v_mfma_f32_16x16x32_bf16 v[36:39], v[60:63], v[56:59], v[36:39]
    s_waitcnt lgkmcnt(3)
    v_mfma_f32_16x16x32_bf16 v[40:43], v[64:67], v[56:59], v[40:43]
    s_waitcnt lgkmcnt(1)
    v_mfma_f32_16x16x32_bf16 v[44:47], v[68:71], v[56:59], v[44:47]
    v_mov_b32 v1, s42
    ds_write_b32 v3, v1
    s_cmpk_lg_u32 s42, 880
    s_cbranch_scc1 standalone__gqa_softmax__sampling_kernel_vtop
    v_lshrrev_b32 v128, 4, v0
    s_lshl_b32 s3, s20, 11
    s_add_u32 s3, s3, 65536
    v_lshl_add_u32 v140, v0, 4, s3
    v_and_b32 v129, 15, v0
    s_lshl_b32 s3, s20, 7
    s_add_u32 s3, s3, 73728
    v_lshl_add_u32 v141, v129, 3, s3
    v_lshlrev_b32 v145, 3, v129
    s_xor_b32 s3, s2, 8
    s_lshl2_add_u32 s3, s3, s20
    s_lshl_b32 s57, s3, 7
    s_mov_b32 s48, s30
    s_and_b32 s49, s31, 0xffff
    s_mov_b32 s50, 131072
    s_mov_b32 s51, 0x20000
    s_mul_i32 s3, s20, 2304
    s_add_u32 s3, s3, 74752
    v_mul_u32_u24 v129, 144, v129
    v_lshl_add_u32 v129, v128, 3, v129
    v_add_u32 v142, s3, v129
    v_lshrrev_b32 v128, 3, v0
    v_and_b32 v129, 7, v0
    v_lshlrev_b32 v129, 4, v129
    v_lshl_add_u32 v144, v128, 8, v129
    v_mul_u32_u24 v128, 144, v128
    v_add3_u32 v143, v128, v129, s3
    s_lshl2_add_u32 s24, s21, s20
    s_lshl_b32 s25, s24, 12
    s_add_u32 s44, s10, s25
    s_addc_u32 s45, s11, 0
    s_and_b32 s45, s45, 0xffff
    s_movk_i32 s46, 0x1000
    s_lshl_b32 s60, s22, 7
    s_movk_i32 s36, 996
    v_rcp_f32 v14, v48
    v_mov_b32 v49, v9
standalone__gqa_softmax__sampling_kernel_stop:
    v_mov_b32 v1, s42
    ds_write_b32 v3, v1
    ds_read_b32 v2, v7
    ds_read_b64 v[10:11], v13
    v_add_u32 v7, 64, v7
    v_add_u32 v50, s35, v4
    v_add_u32 v51, s35, v5
    s_addk_i32 s35, 8192
    s_bitset0_b32 s35, 16
    s_add_u32 s42, s42, 8
    s_set_gpr_idx_on s41, gpr_idx(SRC0)
    v_mov_b32 v52, v80
    v_mov_b32 v53, v81
    v_mov_b32 v54, v82
    v_mov_b32 v55, v83
    v_mov_b32 v56, v84
    v_mov_b32 v57, v85
    v_mov_b32 v58, v86
    v_mov_b32 v59, v87
    s_set_gpr_idx_off
    s_add_u32 s41, s41, 8
standalone__gqa_softmax__sampling_kernel_WG:
    s_waitcnt lgkmcnt(0)
    v_readfirstlane_b32 s43, v11
    s_cmp_lt_i32 s43, s42
    s_cbranch_scc1 standalone__gqa_softmax__sampling_kernel_spinG
    ds_read_b64_tr_b16 v[80:81], v50 offset:0
    ds_read_b64_tr_b16 v[82:83], v50 offset:2048
    ds_read_b64_tr_b16 v[84:85], v51 offset:0
    ds_read_b64_tr_b16 v[86:87], v51 offset:2048
    ds_read_b64_tr_b16 v[88:89], v50 offset:512
    ds_read_b64_tr_b16 v[90:91], v50 offset:2560
    ds_read_b64_tr_b16 v[92:93], v51 offset:512
    ds_read_b64_tr_b16 v[94:95], v51 offset:2560
    ds_read_b64_tr_b16 v[96:97], v50 offset:4096
    ds_read_b64_tr_b16 v[98:99], v50 offset:6144
    ds_read_b64_tr_b16 v[100:101], v51 offset:4096
    ds_read_b64_tr_b16 v[102:103], v51 offset:6144
    ds_read_b64_tr_b16 v[104:105], v50 offset:4608
    ds_read_b64_tr_b16 v[106:107], v50 offset:6656
    v_pk_mul_f32 v[32:33], v[32:33], v[2:3] op_sel_hi:[1,0]
    v_pk_mul_f32 v[34:35], v[34:35], v[2:3] op_sel_hi:[1,0]
    v_pk_mul_f32 v[36:37], v[36:37], v[2:3] op_sel_hi:[1,0]
    v_pk_mul_f32 v[38:39], v[38:39], v[2:3] op_sel_hi:[1,0]
    v_pk_mul_f32 v[40:41], v[40:41], v[2:3] op_sel_hi:[1,0]
    v_pk_mul_f32 v[42:43], v[42:43], v[2:3] op_sel_hi:[1,0]
    v_pk_mul_f32 v[44:45], v[44:45], v[2:3] op_sel_hi:[1,0]
    v_pk_mul_f32 v[46:47], v[46:47], v[2:3] op_sel_hi:[1,0]
    s_waitcnt lgkmcnt(10)
    v_mfma_f32_16x16x32_bf16 v[32:35], v[80:83], v[52:55], v[32:35]
    ds_read_b64_tr_b16 v[108:109], v51 offset:4608
    ds_read_b64_tr_b16 v[110:111], v51 offset:6656
    v_mfma_f32_16x16x32_bf16 v[36:39], v[84:87], v[52:55], v[36:39]
    s_waitcnt lgkmcnt(8)
    v_mfma_f32_16x16x32_bf16 v[40:43], v[88:91], v[52:55], v[40:43]
    v_mfma_f32_16x16x32_bf16 v[44:47], v[92:95], v[52:55], v[44:47]
    s_waitcnt lgkmcnt(4)
    v_mfma_f32_16x16x32_bf16 v[32:35], v[96:99], v[56:59], v[32:35]
    v_mfma_f32_16x16x32_bf16 v[36:39], v[100:103], v[56:59], v[36:39]
    s_waitcnt lgkmcnt(0)
    v_mfma_f32_16x16x32_bf16 v[40:43], v[104:107], v[56:59], v[40:43]
    v_mfma_f32_16x16x32_bf16 v[44:47], v[108:111], v[56:59], v[44:47]
    s_cmpk_lg_u32 s42, 952
    s_cbranch_scc1 standalone__gqa_softmax__sampling_kernel_stop
    ds_write_b64 v141, v[48:49]
    v_subrev_u32 v7, 576, v7
    s_sub_u32 s41, s41, 72
    v_pk_mul_f32 v[32:33], v[32:33], v[14:15] op_sel_hi:[1,0]
    v_cvt_pk_bf16_f32 v128, v32, v33
    v_pk_mul_f32 v[34:35], v[34:35], v[14:15] op_sel_hi:[1,0]
    v_cvt_pk_bf16_f32 v129, v34, v35
    v_pk_mul_f32 v[36:37], v[36:37], v[14:15] op_sel_hi:[1,0]
    v_cvt_pk_bf16_f32 v130, v36, v37
    v_pk_mul_f32 v[38:39], v[38:39], v[14:15] op_sel_hi:[1,0]
    v_cvt_pk_bf16_f32 v131, v38, v39
    ds_write_b128 v140, v[128:131] offset:0
    v_pk_mul_f32 v[40:41], v[40:41], v[14:15] op_sel_hi:[1,0]
    v_cvt_pk_bf16_f32 v132, v40, v41
    v_pk_mul_f32 v[42:43], v[42:43], v[14:15] op_sel_hi:[1,0]
    v_cvt_pk_bf16_f32 v133, v42, v43
    v_pk_mul_f32 v[44:45], v[44:45], v[14:15] op_sel_hi:[1,0]
    v_cvt_pk_bf16_f32 v134, v44, v45
    v_pk_mul_f32 v[46:47], v[46:47], v[14:15] op_sel_hi:[1,0]
    v_cvt_pk_bf16_f32 v135, v46, v47
    ds_write_b128 v140, v[132:135] offset:1024
standalone__gqa_softmax__sampling_kernel_ktop:
    v_mov_b32 v1, s42
    ds_write_b32 v3, v1
    ds_read_b32 v2, v7
    ds_read_b64 v[10:11], v13
    v_add_u32 v7, 64, v7
    v_add_u32 v50, s35, v4
    v_add_u32 v51, s35, v5
    s_addk_i32 s35, 8192
    s_bitset0_b32 s35, 16
    s_add_u32 s42, s42, 8
    s_set_gpr_idx_on s41, gpr_idx(SRC0)
    v_mov_b32 v52, v80
    v_mov_b32 v53, v81
    v_mov_b32 v54, v82
    v_mov_b32 v55, v83
    v_mov_b32 v56, v84
    v_mov_b32 v57, v85
    v_mov_b32 v58, v86
    v_mov_b32 v59, v87
    s_set_gpr_idx_off
    s_add_u32 s41, s41, 8
standalone__gqa_softmax__sampling_kernel_WF:
    s_waitcnt lgkmcnt(0)
    v_readfirstlane_b32 s43, v11
    v_readfirstlane_b32 s3, v10
    s_mul_i32 s3, s3, s43
    s_cmp_ge_u32 s3, s36
    s_cbranch_scc1 standalone__gqa_softmax__sampling_kernel_fetch
standalone__gqa_softmax__sampling_kernel_CF:
    s_cmp_lt_i32 s43, s42
    s_cbranch_scc1 standalone__gqa_softmax__sampling_kernel_spinF
    ds_read_b64_tr_b16 v[80:81], v50 offset:0
    ds_read_b64_tr_b16 v[82:83], v50 offset:2048
    ds_read_b64_tr_b16 v[84:85], v51 offset:0
    ds_read_b64_tr_b16 v[86:87], v51 offset:2048
    ds_read_b64_tr_b16 v[88:89], v50 offset:512
    ds_read_b64_tr_b16 v[90:91], v50 offset:2560
    ds_read_b64_tr_b16 v[92:93], v51 offset:512
    ds_read_b64_tr_b16 v[94:95], v51 offset:2560
    ds_read_b64_tr_b16 v[96:97], v50 offset:4096
    ds_read_b64_tr_b16 v[98:99], v50 offset:6144
    ds_read_b64_tr_b16 v[100:101], v51 offset:4096
    ds_read_b64_tr_b16 v[102:103], v51 offset:6144
    ds_read_b64_tr_b16 v[104:105], v50 offset:4608
    ds_read_b64_tr_b16 v[106:107], v50 offset:6656
    v_pk_mul_f32 v[16:17], v[16:17], v[2:3] op_sel_hi:[1,0]
    v_pk_mul_f32 v[18:19], v[18:19], v[2:3] op_sel_hi:[1,0]
    v_pk_mul_f32 v[20:21], v[20:21], v[2:3] op_sel_hi:[1,0]
    v_pk_mul_f32 v[22:23], v[22:23], v[2:3] op_sel_hi:[1,0]
    v_pk_mul_f32 v[24:25], v[24:25], v[2:3] op_sel_hi:[1,0]
    v_pk_mul_f32 v[26:27], v[26:27], v[2:3] op_sel_hi:[1,0]
    v_pk_mul_f32 v[28:29], v[28:29], v[2:3] op_sel_hi:[1,0]
    v_pk_mul_f32 v[30:31], v[30:31], v[2:3] op_sel_hi:[1,0]
    s_waitcnt lgkmcnt(10)
    v_mfma_f32_16x16x32_bf16 v[16:19], v[80:83], v[52:55], v[16:19]
    ds_read_b64_tr_b16 v[108:109], v51 offset:4608
    ds_read_b64_tr_b16 v[110:111], v51 offset:6656
    v_mfma_f32_16x16x32_bf16 v[20:23], v[84:87], v[52:55], v[20:23]
    s_waitcnt lgkmcnt(8)
    v_mfma_f32_16x16x32_bf16 v[24:27], v[88:91], v[52:55], v[24:27]
    v_mfma_f32_16x16x32_bf16 v[28:31], v[92:95], v[52:55], v[28:31]
    s_waitcnt lgkmcnt(4)
    v_mfma_f32_16x16x32_bf16 v[16:19], v[96:99], v[56:59], v[16:19]
    v_mfma_f32_16x16x32_bf16 v[20:23], v[100:103], v[56:59], v[20:23]
    s_waitcnt lgkmcnt(0)
    v_mfma_f32_16x16x32_bf16 v[24:27], v[104:107], v[56:59], v[24:27]
    v_mfma_f32_16x16x32_bf16 v[28:31], v[108:111], v[56:59], v[28:31]
    s_cmpk_lg_u32 s42, 1024
    s_cbranch_scc1 standalone__gqa_softmax__sampling_kernel_ktop
    s_add_u32 s42, s42, 1
    s_cmp_le_u32 s36, s42
    s_cbranch_scc1 standalone__gqa_softmax__sampling_kernel_spinF
standalone__gqa_softmax__sampling_kernel_final:
    s_waitcnt vmcnt(2)
    v_max_f32 v12, v9, v137
    v_sub_f32 v14, v9, v12
    v_sub_f32 v12, v137, v12
    v_exp_f32 v12, v12
    v_exp_f32 v14, v14
    v_mul_f32 v12, v12, v136
    v_fma_f32 v8, v14, v48, v12
    v_rcp_f32 v8, v8
    s_waitcnt vmcnt(1)
    v_lshlrev_b32 v112, 16, v128
    v_and_b32 v113, 0xffff0000, v128
    v_lshlrev_b32 v114, 16, v129
    v_and_b32 v115, 0xffff0000, v129
    v_mul_f32 v14, v14, v8
    v_mul_f32 v12, v12, v8
    v_pk_mul_f32 v[16:17], v[16:17], v[14:15] op_sel_hi:[1,0]
    v_pk_mul_f32 v[18:19], v[18:19], v[14:15] op_sel_hi:[1,0]
    v_pk_fma_f32 v[16:17], v[112:113], v[12:13], v[16:17] op_sel_hi:[1,0,1]
    v_pk_fma_f32 v[18:19], v[114:115], v[12:13], v[18:19] op_sel_hi:[1,0,1]
    v_cvt_pk_bf16_f32 v52, v16, v17
    v_cvt_pk_bf16_f32 v53, v18, v19
    ds_write_b64 v142, v[52:53] offset:0
    v_lshlrev_b32 v116, 16, v130
    v_and_b32 v117, 0xffff0000, v130
    v_lshlrev_b32 v118, 16, v131
    v_and_b32 v119, 0xffff0000, v131
    v_pk_mul_f32 v[20:21], v[20:21], v[14:15] op_sel_hi:[1,0]
    v_pk_mul_f32 v[22:23], v[22:23], v[14:15] op_sel_hi:[1,0]
    v_pk_fma_f32 v[20:21], v[116:117], v[12:13], v[20:21] op_sel_hi:[1,0,1]
    v_pk_fma_f32 v[22:23], v[118:119], v[12:13], v[22:23] op_sel_hi:[1,0,1]
    v_cvt_pk_bf16_f32 v54, v20, v21
    v_cvt_pk_bf16_f32 v55, v22, v23
    ds_write_b64 v142, v[54:55] offset:32
    s_waitcnt vmcnt(0)
    v_lshlrev_b32 v120, 16, v132
    v_and_b32 v121, 0xffff0000, v132
    v_lshlrev_b32 v122, 16, v133
    v_and_b32 v123, 0xffff0000, v133
    v_pk_mul_f32 v[24:25], v[24:25], v[14:15] op_sel_hi:[1,0]
    v_pk_mul_f32 v[26:27], v[26:27], v[14:15] op_sel_hi:[1,0]
    v_pk_fma_f32 v[24:25], v[120:121], v[12:13], v[24:25] op_sel_hi:[1,0,1]
    v_pk_fma_f32 v[26:27], v[122:123], v[12:13], v[26:27] op_sel_hi:[1,0,1]
    v_cvt_pk_bf16_f32 v56, v24, v25
    v_cvt_pk_bf16_f32 v57, v26, v27
    ds_write_b64 v142, v[56:57] offset:64
    v_lshlrev_b32 v124, 16, v134
    v_and_b32 v125, 0xffff0000, v134
    v_lshlrev_b32 v126, 16, v135
    v_and_b32 v127, 0xffff0000, v135
    v_pk_mul_f32 v[28:29], v[28:29], v[14:15] op_sel_hi:[1,0]
    v_pk_mul_f32 v[30:31], v[30:31], v[14:15] op_sel_hi:[1,0]
    v_pk_fma_f32 v[28:29], v[124:125], v[12:13], v[28:29] op_sel_hi:[1,0,1]
    v_pk_fma_f32 v[30:31], v[126:127], v[12:13], v[30:31] op_sel_hi:[1,0,1]
    v_cvt_pk_bf16_f32 v58, v28, v29
    v_cvt_pk_bf16_f32 v59, v30, v31
    ds_write_b64 v142, v[58:59] offset:96
    ds_read_b128 v[80:83], v143 offset:0
    ds_read_b128 v[84:87], v143 offset:1152
    s_waitcnt lgkmcnt(1)
    buffer_store_dwordx4 v[80:83], v144, s[44:47], s60 offen offset:0
    s_waitcnt lgkmcnt(0)
    buffer_store_dwordx4 v[84:87], v144, s[44:47], s60 offen offset:2048
    s_endpgm
standalone__gqa_softmax__sampling_kernel_fetch:
    buffer_load_dwordx2 v[136:137], v145, s[48:51], s57 offen sc1 nt
    buffer_load_dwordx4 v[128:131], v144, s[44:47], s60 offen offset:0 sc1 nt
    buffer_load_dwordx4 v[132:135], v144, s[44:47], s60 offen offset:2048 sc1 nt
    s_movk_i32 s36, 0x7fff
    s_cmpk_gt_u32 s42, 1024
    s_cbranch_scc1 standalone__gqa_softmax__sampling_kernel_final
    s_branch standalone__gqa_softmax__sampling_kernel_CF
standalone__gqa_softmax__sampling_kernel_spinK:
    ds_read_b64 v[10:11], v13
    s_branch standalone__gqa_softmax__sampling_kernel_WK
standalone__gqa_softmax__sampling_kernel_spinV0:
    ds_read_b64 v[10:11], v13
    s_branch standalone__gqa_softmax__sampling_kernel_WV0
standalone__gqa_softmax__sampling_kernel_spinV1:
    ds_read_b64 v[10:11], v13
    s_branch standalone__gqa_softmax__sampling_kernel_WV1
standalone__gqa_softmax__sampling_kernel_spinG:
    ds_read_b64 v[10:11], v13
    s_branch standalone__gqa_softmax__sampling_kernel_WG
standalone__gqa_softmax__sampling_kernel_spinF:
    ds_read_b64 v[10:11], v13
    s_branch standalone__gqa_softmax__sampling_kernel_WF
standalone__gqa_softmax__sampling_kernel_tolds:
    v_cvt_pk_bf16_f32 v32, v32, v33
    v_cvt_pk_bf16_f32 v33, v34, v35
    v_cvt_pk_bf16_f32 v34, v36, v37
    v_cvt_pk_bf16_f32 v35, v38, v39
    ds_write_b128 v15, v[32:35] offset:0
    v_cvt_pk_bf16_f32 v36, v40, v41
    v_cvt_pk_bf16_f32 v37, v42, v43
    v_cvt_pk_bf16_f32 v38, v44, v45
    v_cvt_pk_bf16_f32 v39, v46, v47
    ds_write_b128 v15, v[36:39] offset:1024
    v_add_u32 v15, 0x2000, v15
    s_branch standalone__gqa_softmax__sampling_kernel_WK
standalone__gqa_softmax__sampling_kernel_fromlds:
    ds_read_b128 v[52:55], v15 offset:0
    ds_read_b128 v[56:59], v15 offset:1024
    v_add_u32 v15, 0x2000, v15
    s_branch standalone__gqa_softmax__sampling_kernel_havep
standalone__gqa_softmax__sampling_kernel_fin:
standalone__gqa_softmax__sampling_kernel_done:
    s_endpgm
.section .rodata,"a"
.p2align 6
.amdhsa_kernel standalone__gqa_softmax__sampling_kernel
  .amdhsa_next_free_vgpr 256
  .amdhsa_next_free_sgpr 102
  .amdhsa_accum_offset 256
  .amdhsa_group_segment_fixed_size 0
  .amdhsa_kernarg_size 48
  .amdhsa_user_sgpr_count 2
  .amdhsa_user_sgpr_kernarg_segment_ptr 1
  .amdhsa_system_sgpr_workgroup_id_x 1
.end_amdhsa_kernel
```
